```python
import torch

def _softmax(x, axis=-1):
    return torch.softmax(x, dim=axis)
def _gelu(x):
    return torch.nn.functional.gelu(x, approximate="tanh")
def _silu(x):
    return torch.nn.functional.silu(x)
def _sigmoid(x):
    return torch.sigmoid(x)
def _layernorm(x, axis=-1, eps=1e-5):
    m = x.mean(dim=axis, keepdim=True)
    v = x.var(dim=axis, keepdim=True, unbiased=False)
    return (x - m) / torch.sqrt(v + eps)
def _scatter_add(tgt, idx, src, axis=0):
    return tgt.clone().index_add_(axis, idx, src)
def _segment_sum(src, seg, n):
    out = torch.zeros((n,) + src.shape[1:], dtype=src.dtype)
    return out.index_add_(0, seg, src)
def _pad(x, pw):
    flat = tuple(v for pair in reversed(pw) for v in pair)
    return torch.nn.functional.pad(x, flat)

kernel_name = 'parallel_sum__sliding_block_cached__dense_activation_silu__decode'

def setup_inputs():

    _w = (lambda a: (lambda t: t.to(torch.bfloat16) if t.is_floating_point() else t)(torch.as_tensor(a)))
    def _A_setup():
        B, Sq, D = 8, 1, 512
        Hq, Hkv, Sk, Dh = 32, 8, 4096, 128
        assert Hq % Hkv == 0, (Hq, Hkv)
        return {
            "x": _w((lambda *s: torch.randn(*s, dtype=torch.bfloat16) * 0.05)(B, Sq, D)),
            "k_cache": _w((lambda *s: torch.randn(*s, dtype=torch.bfloat16) * 3.2)(B, Hkv, Sk, Dh)),
            "v_cache": _w((lambda *s: torch.randn(*s, dtype=torch.bfloat16) * 0.8)(B, Hkv, Sk, Dh)),
            "wq": _w((lambda *s: torch.randn(*s, dtype=torch.bfloat16) * 3.2)(D, Hq * Dh) * (D ** -0.5)),
            "wo": _w((lambda *s: torch.randn(*s, dtype=torch.bfloat16) * 0.8)(Hq * Dh, D) * ((Hq * Dh) ** -0.5)),
        }
    _A_in = _A_setup()

    def _B_setup():
        B, S, D, F = 8, 1, 512, 1792
        return {
            "x": _w((lambda *s: torch.randn(*s, dtype=torch.bfloat16) * 0.05)(B, S, D)),
            "w1": _w((lambda *s: torch.randn(*s, dtype=torch.bfloat16) * 3.2)(D, F) * (D ** -0.5)),
            "w2": _w((lambda *s: torch.randn(*s, dtype=torch.bfloat16) * 0.4)(F, D) * (F ** -0.5)),
        }
    _B_in = _B_setup()

    return {
        "A_x": _A_in["x"],
        "A_k_cache": _A_in["k_cache"],
        "A_v_cache": _A_in["v_cache"],
        "A_wq": _A_in["wq"],
        "A_wo": _A_in["wo"],
        "B_x": _B_in["x"],
        "B_w1": _B_in["w1"],
        "B_w2": _B_in["w2"],
    }

def reference(A_x, A_k_cache, A_v_cache, A_wq, A_wo, B_x, B_w1, B_w2):
    def _A_ref(x, k_cache, v_cache, wq, wo):
        B, Sq, D = x.shape
        Hq, Dh = 32, 128
        Hkv, Sk = k_cache.shape[1], k_cache.shape[2]
        W = min(4096, max(256, Sk // 4))
        rep = Hq // Hkv
        q = (lambda x, *d: x.permute(*d))((x @ wq).reshape(B, Sq, Hq, Dh), 0, 2, 1, 3)
        k = (lambda x, n, axis: torch.repeat_interleave(x, n, dim=axis))(k_cache[:, :, Sk - W:, :], rep, axis=1)
        v = (lambda x, n, axis: torch.repeat_interleave(x, n, dim=axis))(v_cache[:, :, Sk - W:, :], rep, axis=1)
        scores = torch.einsum("bhqd,bhkd->bhqk", q, k) * (Dh ** -0.5)
        p = _softmax(scores, axis=-1)
        o = torch.einsum("bhqk,bhkd->bhqd", p, v)
        return (lambda x, *d: x.permute(*d))(o, 0, 2, 1, 3).reshape(B, Sq, Hq * Dh) @ wo

    def _B_ref(x, w1, w2):
        h = torch.einsum("bsd,df->bsf", x, w1)
        h = _silu(h)
        out = torch.einsum("bsf,fd->bsd", h, w2)
        return out

    x = A_x
    xn = _layernorm(x, axis=-1)
    return x + _A_ref(xn, A_k_cache, A_v_cache, A_wq, A_wo) + _B_ref(xn, B_w1, B_w2)
```

```asm
; @launch grid=(256,1,1) block=(384,1,1) lds=163840
.amdgcn_target "amdgcn-amd-amdhsa--gfx950"
.text
.globl parallel_sum__sliding_block_cached__dense_activation_silu__decode_kernel
.p2align 12
.fill 896, 4, 0xbf810000
.p2align 8
.type parallel_sum__sliding_block_cached__dense_activation_silu__decode_kernel,@function
parallel_sum__sliding_block_cached__dense_activation_silu__decode_kernel:
L_start:
    s_load_dwordx2 s[36:37], s[0:1], 24
    s_load_dwordx2 s[40:41], s[0:1], 0
    s_lshr_b32 s27, s2, 3
    s_cmp_ge_u32 s27, 32
    s_cbranch_scc1 L_end
    s_getpc_b64 s[44:45]
    v_lshlrev_b32 v3, 5, v0
    global_load_dword v254, v3, s[44:45]
    v_readfirstlane_b32 s3, v0
    v_bfe_u32 v6, v0, 3, 3
    v_and_b32 v7, 7, v0
    v_and_b32 v14, 6, v6
    v_xor_b32 v14, v14, v7
    v_lshlrev_b32 v14, 4, v14
    s_bitcmp1_b32 s3, 8
    s_cbranch_scc1 L_common
    v_lshl_or_b32 v2, v6, 13, v14
    s_and_b32 s26, s2, 7
    s_and_b32 s30, s27, 7
    s_lshl3_add_u32 s34, s26, s30
    s_lshl_b32 s34, s34, 7
    s_andn2_b32 s33, s2, 63
    s_lshl2_add_u32 s33, s33, s3
    s_lshl_b32 s33, s33, 12
    s_add_u32 s34, s34, s33
    s_lshl_b32 m0, s3, 6
    s_bitset1_b32 m0, 17
    s_mov_b32 s38, -1
    s_mov_b32 s39, 0x20000
    s_mov_b64 s[42:43], s[38:39]
    v_and_b32 v4, 31, v0
    v_lshlrev_b32 v4, 4, v4
    v_sub_u32 v3, v3, v4
    s_movk_i32 s33, 0x7e00
    s_waitcnt lgkmcnt(0)
    buffer_load_dwordx4 v[40:43], v3, s[40:43], 0 offen
    buffer_load_dwordx4 v[44:47], v3, s[40:43], 0 offen offset:512
    buffer_load_dwordx4 v2, s[36:39], s34 offen offset:0 nt lds
    s_lshl1_add_u32 s34, s33, s34
    buffer_load_dwordx4 v2, s[36:39], s34 offen offset:1024 nt lds
    s_lshl1_add_u32 s34, s33, s34
    buffer_load_dwordx4 v2, s[36:39], s34 offen offset:2048 nt lds
    s_lshl1_add_u32 s34, s33, s34
    buffer_load_dwordx4 v2, s[36:39], s34 offen offset:3072 nt lds
L_common:
    s_load_dwordx16 s[4:19], s[0:1], 0
    s_load_dwordx2 s[22:23], s[0:1], 80
    s_lshr_b32 s3, s3, 6
    v_and_b32 v1, 63, v0
    v_mov_b32 v9, 160256
    s_and_b32 s26, s2, 7
    s_lshr_b32 s28, s27, 2
    s_and_b32 s29, s27, 3
    s_and_b32 s30, s27, 7
    s_lshr_b32 s31, s27, 3
    s_lshl2_add_u32 s32, s26, s31
    s_bfm_b32 s35, s32, 0
    s_and_b32 s35, s35, 0xcc0000
    s_bcnt1_i32_b32 s35, s35
    s_sub_u32 s35, s32, s35
    s_bitcmp1_b32 0xcc0000, s32
    s_cselect_b32 s35, 28, s35
    s_mov_b32 s83, 2097152
    v_lshlrev_b32 v8, 4, v1
    s_cmp_lg_u32 s3, 4
    s_cbranch_scc1 L_other
    s_setprio 2
    v_cmp_lt_u32 vcc, 15, v1
    v_lshl_add_u32 v11, v1, 2, v9
    s_nop 0
    v_cndmask_b32 v10, 0, -1, vcc
    ds_write_b32 v11, v10
    s_lshl_b32 s78, s30, 7
    s_mul_i32 s76, s30, 229376
    s_lshl_b32 s77, s35, 7
    s_add_u32 s76, s76, s77
    v_mul_u32_u24 v20, 3584, v6
    v_add3_u32 v20, v20, v14, s76
    v_add_u32 v21, 27648, v20
    v_add_u32 v22, 55296, v20
    v_add_u32 v23, 82944, v20
    s_cmp_lt_u32 s35, 28
    s_cselect_b32 s38, 1835008, 0
    s_mov_b32 s39, 0x20000
    s_movk_i32 s33, 0x1000
    s_mov_b32 m0, 147456
    s_mov_b32 s34, 114688
    s_waitcnt lgkmcnt(0)
    s_mov_b32 s36, s16
    s_mov_b32 s37, s17
    s_barrier
    buffer_load_dwordx4 v20, s[36:39], 0 offen offset:0 nt lds
    buffer_load_dwordx4 v21, s[36:39], 0 offen offset:1024 nt lds
    buffer_load_dwordx4 v22, s[36:39], 0 offen offset:2048 nt lds
    buffer_load_dwordx4 v23, s[36:39], 0 offen offset:3072 nt lds
    s_add_u32 m0, m0, s33
    s_nop 0
    buffer_load_dwordx4 v20, s[36:39], s34 offen offset:0 nt lds
    buffer_load_dwordx4 v21, s[36:39], s34 offen offset:1024 nt lds
    buffer_load_dwordx4 v22, s[36:39], s34 offen offset:2048 nt lds
    buffer_load_dwordx4 v23, s[36:39], s34 offen offset:3072 nt lds
    v_lshrrev_b32 v16, 4, v1
    v_and_b32 v17, 15, v1
    v_xor_b32 v2, v16, v17
    v_lshlrev_b32 v2, 4, v2
    v_lshl_or_b32 v2, v16, 8, v2
    v_xor_b32 v3, 64, v2
    v_xor_b32 v4, 0x80, v2
    v_xor_b32 v5, 0xc0, v2
    s_lshr_b32 s34, s2, 4
    s_add_u32 s34, s34, s2
    s_lshl_b32 s34, s34, 12
    s_and_b32 s34, s34, 0xf000
    s_lshl_b32 s84, s28, 23
    s_lshl_b32 s77, s26, 20
    s_add_u32 s84, s84, s77
    s_lshl_b32 s77, s29, 16
    s_add_u32 s84, s84, s77
    s_add_u32 s84, s84, 786432
    s_add_u32 s36, s6, s84
    s_addc_u32 s37, s7, 0
    s_mov_b32 s38, 65536
    s_mov_b32 m0, 0
    s_mov_b32 s85, 4096
    s_mov_b32 s87, 0xf000
    s_mov_b32 s88, 8
    s_mov_b32 s88, 2
L_pre:
    buffer_load_dwordx4 v2, s[36:39], s34 offen offset:0 nt lds
    buffer_load_dwordx4 v3, s[36:39], s34 offen offset:1024 nt lds
    buffer_load_dwordx4 v4, s[36:39], s34 offen offset:2048 nt lds
    buffer_load_dwordx4 v5, s[36:39], s34 offen offset:3072 nt lds
    s_add_u32 m0, m0, s33
    s_add_u32 s34, s34, s85
    s_and_b32 s34, s34, s87
    s_sub_u32 s88, s88, 1
    s_cmp_lg_u32 s88, 0
    s_cbranch_scc1 L_pre
    s_cmp_lt_u32 s35, 28
    s_cselect_b32 s89, 1, 0
    s_cselect_b32 s88, 2, 1
    s_cmp_eq_u32 s30, 3
    s_cselect_b32 s89, s88, s89
    s_cmp_ge_u32 s89, 2
    s_cselect_b32 s88, -1, 0
    v_mov_b32 v18, s88
    s_mov_b32 s88, 7
    v_and_b32 v10, 3, v6
    v_lshrrev_b32 v11, 2, v6
    s_load_dword s24, s[22:23], 0
    s_load_dwordx2 s[20:21], s[0:1], 64
    s_call_b64 s[90:91], L_stream
    s_waitcnt lgkmcnt(0)
    s_add_u32 s24, s24, 1
    s_and_b32 s25, s24, 15
    s_cselect_b32 s25, 0, 1
    s_add_u32 s24, s24, s25
    s_mov_b32 s52, s22
    s_mov_b32 s53, s23
    s_mov_b32 s54, 3080192
    s_mov_b32 s55, 0x20000
    s_lshl_b32 s76, s26, 7
    s_add_u32 s76, s76, 2048
    s_lshl2_add_u32 s77, s27, s76
    v_mov_b32 v19, s24
    v_lshlrev_b32 v24, 2, v1
    s_mov_b64 exec, 1
    buffer_store_dword v19, v24, s[52:55], s77 offen
    s_mov_b32 exec_lo, -1
    buffer_load_dword v25, v24, s[52:55], s76 offen sc1
    s_mov_b32 exec_hi, -1
    v_lshlrev_b32 v2, 1, v16
    v_xor_b32 v2, v2, v17
    v_lshlrev_b32 v2, 4, v2
    v_lshl_or_b32 v2, v16, 8, v2
    v_xor_b32 v3, 0x80, v2
    v_mov_b32 v4, v2
    v_xor_b32 v5, 0x80, v2
    s_add_u32 s36, s8, s84
    s_addc_u32 s37, s9, 0
    s_mov_b32 s88, 4
L_w4_1:
    s_sub_u32 s83, s83, 1
    s_cbranch_scc1 L_out
    ds_read_b128 v[20:23], v9 offset:32
    s_waitcnt lgkmcnt(0)
    v_min3_u32 v19, v20, v21, v22
    v_min_u32 v19, v19, v23
    v_cmp_eq_u32 vcc, 0, v19
    s_cbranch_vccnz L_w4_1
    s_call_b64 s[90:91], L_stream
    v_cmp_eq_u32 vcc, s24, v25
    s_mov_b32 s89, 0
    s_bcnt1_i32_b32 s76, vcc_lo
    s_cmp_gt_u32 s76, 10
    s_addc_u32 s89, s89, 0
    s_cmp_gt_u32 s76, 18
    s_addc_u32 s89, s89, 0
    s_cmp_gt_u32 s76, 25
    s_addc_u32 s89, s89, 0
    s_cmp_ge_u32 s35, 28
    s_subb_u32 s89, s89, 0
    s_max_i32 s89, s89, 0
    s_cmp_eq_u32 s30, 3
    s_addc_u32 s89, s89, 0
    s_min_u32 s89, s89, 3
    s_cmp_ge_u32 s89, 2
    s_cselect_b32 s88, 10, 11
    v_mov_b32 v18, s88
    s_mov_b32 s88, 4
    s_call_b64 s[90:91], L_stream
L_w4_2:
    s_sub_u32 s83, s83, 1
    s_cbranch_scc1 L_out
    ds_read_b128 v[20:23], v9 offset:48
    s_waitcnt lgkmcnt(0)
    v_min3_u32 v19, v20, v21, v22
    v_min_u32 v19, v19, v23
    v_cmp_eq_u32 vcc, 0, v19
    s_cbranch_vccnz L_w4_2
    v_max3_u32 v19, v20, v21, v22
    v_max_u32 v19, v19, v23
    v_add3_u32 v20, v20, v21, v22
    v_add_u32 v20, v20, v23
    v_readfirstlane_b32 s97, v19
    v_readfirstlane_b32 s81, v20
    s_lshr_b32 s97, s97, 16
    s_and_b32 s81, s81, 0xffff
    s_cmp_gt_u32 s81, 512
    s_cselect_b32 s81, 0, 4
    s_xor_b32 s81, s81, s26
    s_bitcmp1_b32 s81, 2
    s_cselect_b32 s81, 532480, 0
    s_mov_b32 s52, s22
    s_mov_b32 s53, s23
    s_mov_b32 s54, 3080192
    s_mov_b32 s55, 0x20000
    s_mov_b32 s56, s20
    s_mov_b32 s57, s21
    s_mov_b32 s58, 8192
    s_mov_b32 s59, 0x20000
    s_mov_b32 s40, s4
    s_mov_b32 s41, s5
    s_mov_b32 s42, 8192
    s_mov_b32 s43, 0x20000
    s_lshl_b32 s68, s26, 5
    s_add_u32 s68, s68, s27
    s_lshl_b32 s68, s68, 6
    s_xor_b32 s68, s68, s81
    s_add_u32 s68, s68, 1048576
    s_add_u32 s69, s68, 262144
    v_lshrrev_b32 v28, 2, v1
    v_lshlrev_b32 v28, 14, v28
    v_and_b32 v29, 3, v1
    v_lshl_or_b32 v28, v29, 4, v28
    v_bfe_u32 v30, v1, 3, 1
    v_bfe_u32 v31, v1, 2, 1
    v_lshl_or_b32 v30, v31, 1, v30
    v_lshlrev_b32 v30, 10, v30
    v_lshl_or_b32 v30, v29, 1, v30
    s_bfe_u32 s70, s27, 0x10002
    s_lshl_b32 s70, s70, 12
    s_lshl_b32 s71, s26, 7
    s_add_u32 s70, s70, s71
    s_lshl_b32 s71, s31, 5
    s_add_u32 s70, s70, s71
    s_lshl3_add_u32 s70, s29, s70
    buffer_load_ushort v13, v30, s[40:43], s70 offen
    v_lshlrev_b32 v12, 14, v1
    s_mov_b32 exec_hi, 0
    buffer_load_dword v253, v12, s[52:55], s68 offen sc1
    s_mov_b32 exec_hi, -1
    s_lshl_b32 s76, s26, 19
    s_lshl_b32 s77, s31, 15
    s_add_u32 s76, s76, s77
    s_add_u32 s76, s76, s78
    v_lshl_or_b32 v2, v10, 17, v14
    v_lshl_or_b32 v2, v11, 10, v2
    v_add_u32 v2, s76, v2
    v_add_u32 v3, 0x400, v2
    v_add_u32 v4, 0x800, v2
    v_add_u32 v5, 0xc00, v2
    s_mov_b32 s36, s12
    s_mov_b32 s37, s13
    s_mov_b32 s38, 4194304
    s_mov_b32 s34, 0
    s_movk_i32 s85, 0x2000
    s_mov_b32 s87, -1
    s_mov_b32 s88, 2
    s_call_b64 s[90:91], L_stream
    s_lshl_b32 s76, s35, 16
    s_add_u32 s76, s76, s78
    v_mul_u32_u24 v2, 1024, v6
    v_add3_u32 v2, v2, v14, s76
    v_add_u32 v3, 7168, v2
    v_add_u32 v4, 14336, v2
    v_add_u32 v5, 21504, v2
    s_mov_b32 s36, s18
    s_mov_b32 s37, s19
    s_mov_b32 s38, 1835008
    s_mov_b32 s34, 0
    s_mov_b32 s85, 0x8000
    s_mov_b32 s88, 1
    s_call_b64 s[90:91], L_stream
    s_waitcnt vmcnt(24)
    v_mov_b32 v18, 17
    ds_write_b32 v9, v18 offset:0
    s_waitcnt vmcnt(16)
    v_mov_b32 v18, 18
    ds_write_b32 v9, v18 offset:0
    s_waitcnt vmcnt(8)
    v_mov_b32 v18, 19
    ds_write_b32 v9, v18 offset:0
    s_waitcnt vmcnt(0)
    v_mov_b32 v18, 20
    ds_write_b32 v9, v18 offset:0
    s_waitcnt lgkmcnt(0)
    s_barrier
    buffer_load_dwordx4 v[20:23], v28, s[52:55], s68 offen offset:0 sc1
    buffer_load_dwordx4 v[24:27], v28, s[52:55], s69 offen offset:0 sc1
    s_branch L_gw_4
L_gr_3:
    v_and_b32 v10, 15, v10
    v_and_b32 v11, 15, v11
    v_cmp_ne_u32 s[60:61], 0, v10
    v_cmp_ne_u32 s[62:63], 0, v11
    s_sub_u32 s83, s83, 1
    s_cbranch_scc1 L_out
    s_wqm_b64 exec, s[60:61]
    buffer_load_dwordx4 v[20:23], v28, s[52:55], s68 offen offset:0 sc1
    s_wqm_b64 exec, s[62:63]
    buffer_load_dwordx4 v[24:27], v28, s[52:55], s69 offen offset:0 sc1
    s_mov_b64 exec, -1
    s_waitcnt vmcnt(0)
L_gw_4:
    s_waitcnt vmcnt(1)
    v_bitop3_b32 v10, v20, v21, s24 bitop3:0x7e
    v_bitop3_b32 v10, v10, v22, s24 bitop3:0xf6
    v_bitop3_b32 v10, v10, v23, s24 bitop3:0xf6
    s_waitcnt vmcnt(0)
    v_bitop3_b32 v11, v24, v25, s24 bitop3:0x7e
    v_bitop3_b32 v11, v11, v26, s24 bitop3:0xf6
    v_bitop3_b32 v11, v11, v27, s24 bitop3:0xf6
    v_bitop3_b32 v12, v10, v11, 15 bitop3:0xa8
    v_cmp_ne_u32 vcc, 0, v12
    s_cbranch_vccnz L_gr_3
    v_lshlrev_b32 v13, 16, v13
L_fin_red:
    v_add_f32 v20, v20, v24
    v_add_f32 v21, v21, v25
    v_add_f32 v22, v22, v26
    v_add_f32 v23, v23, v27
    v_add_f32_dpp v24, v20, v20 row_ror:8 row_mask:0xf bank_mask:0x3
    v_add_f32_dpp v25, v22, v22 row_ror:8 row_mask:0xf bank_mask:0x3
    s_nop 0
    v_add_f32_dpp v24, v21, v21 row_ror:8 row_mask:0xf bank_mask:0xc
    v_add_f32_dpp v25, v23, v23 row_ror:8 row_mask:0xf bank_mask:0xc
    s_nop 0
    v_add_f32_dpp v20, v24, v24 row_ror:12 row_mask:0xf bank_mask:0x5
    s_nop 1
    v_add_f32_dpp v20, v25, v25 row_ror:4 row_mask:0xf bank_mask:0xa
    v_mov_b32 v21, v20
    s_nop 1
    v_permlane16_swap_b32 v20, v21
    v_add_f32 v20, v20, v21
    v_mov_b32 v21, v20
    s_nop 1
    v_permlane32_swap_b32 v20, v21
    v_add_f32 v20, v20, v21
    v_add_f32 v20, v20, v13
    v_cvt_pk_bf16_f32 v20, v20, v20
    s_mov_b64 exec, 0xffff
    buffer_store_short v20, v30, s[56:59], s70 offen
    s_cmp_lg_u32 s2, 0
    s_cbranch_scc1 L_fin_done
    s_mov_b64 exec, 1
    v_mov_b32 v12, s24
    v_mov_b32 v11, 0
    buffer_store_dword v12, v11, s[52:55], 0 offen sc1
L_fin_done:
    s_endpgm
L_stream:
    s_cmp_eq_u32 s89, 1
    s_cbranch_scc1 L_stream1
    s_cmp_eq_u32 s89, 2
    s_cbranch_scc1 L_stream2
    s_cmp_eq_u32 s89, 3
    s_cbranch_scc1 L_stream3
L_stream0:
    s_waitcnt vmcnt(19)
    buffer_load_dwordx4 v2, s[36:39], s34 offen offset:0 nt lds
    s_waitcnt vmcnt(19)
    buffer_load_dwordx4 v3, s[36:39], s34 offen offset:1024 nt lds
    s_waitcnt vmcnt(19)
    buffer_load_dwordx4 v4, s[36:39], s34 offen offset:2048 nt lds
    s_waitcnt vmcnt(19)
    ds_write_b32 v9, v18 offset:0
    v_add_u32 v18, 1, v18
    buffer_load_dwordx4 v5, s[36:39], s34 offen offset:3072 nt lds
    s_add_u32 m0, m0, s33
    s_add_u32 s34, s34, s85
    s_and_b32 s34, s34, s87
    s_waitcnt vmcnt(19)
    buffer_load_dwordx4 v2, s[36:39], s34 offen offset:0 nt lds
    s_waitcnt vmcnt(19)
    buffer_load_dwordx4 v3, s[36:39], s34 offen offset:1024 nt lds
    s_waitcnt vmcnt(19)
    buffer_load_dwordx4 v4, s[36:39], s34 offen offset:2048 nt lds
    s_waitcnt vmcnt(19)
    buffer_load_dwordx4 v5, s[36:39], s34 offen offset:3072 nt lds
    s_add_u32 m0, m0, s33
    s_add_u32 s34, s34, s85
    s_and_b32 s34, s34, s87
    s_sub_u32 s88, s88, 1
    s_cmp_lg_u32 s88, 0
    s_cbranch_scc1 L_stream0
    s_setpc_b64 s[90:91]
L_stream1:
    s_waitcnt vmcnt(21)
    buffer_load_dwordx4 v2, s[36:39], s34 offen offset:0 nt lds
    s_waitcnt vmcnt(21)
    buffer_load_dwordx4 v3, s[36:39], s34 offen offset:1024 nt lds
    s_waitcnt vmcnt(21)
    buffer_load_dwordx4 v4, s[36:39], s34 offen offset:2048 nt lds
    s_waitcnt vmcnt(21)
    buffer_load_dwordx4 v5, s[36:39], s34 offen offset:3072 nt lds
    s_add_u32 m0, m0, s33
    s_add_u32 s34, s34, s85
    s_and_b32 s34, s34, s87
    s_waitcnt vmcnt(21)
    buffer_load_dwordx4 v2, s[36:39], s34 offen offset:0 nt lds
    s_waitcnt vmcnt(21)
    ds_write_b32 v9, v18 offset:0
    v_add_u32 v18, 1, v18
    buffer_load_dwordx4 v3, s[36:39], s34 offen offset:1024 nt lds
    s_waitcnt vmcnt(21)
    buffer_load_dwordx4 v4, s[36:39], s34 offen offset:2048 nt lds
    s_waitcnt vmcnt(21)
    buffer_load_dwordx4 v5, s[36:39], s34 offen offset:3072 nt lds
    s_add_u32 m0, m0, s33
    s_add_u32 s34, s34, s85
    s_and_b32 s34, s34, s87
    s_sub_u32 s88, s88, 1
    s_cmp_lg_u32 s88, 0
    s_cbranch_scc1 L_stream1
    s_setpc_b64 s[90:91]
L_stream2:
    s_waitcnt vmcnt(24)
    ds_write_b32 v9, v18 offset:0
    v_add_u32 v18, 1, v18
    buffer_load_dwordx4 v2, s[36:39], s34 offen offset:0 nt lds
    s_waitcnt vmcnt(24)
    buffer_load_dwordx4 v3, s[36:39], s34 offen offset:1024 nt lds
    s_waitcnt vmcnt(24)
    buffer_load_dwordx4 v4, s[36:39], s34 offen offset:2048 nt lds
    s_waitcnt vmcnt(24)
    buffer_load_dwordx4 v5, s[36:39], s34 offen offset:3072 nt lds
    s_add_u32 m0, m0, s33
    s_add_u32 s34, s34, s85
    s_and_b32 s34, s34, s87
    s_waitcnt vmcnt(24)
    buffer_load_dwordx4 v2, s[36:39], s34 offen offset:0 nt lds
    s_waitcnt vmcnt(24)
    buffer_load_dwordx4 v3, s[36:39], s34 offen offset:1024 nt lds
    s_waitcnt vmcnt(24)
    buffer_load_dwordx4 v4, s[36:39], s34 offen offset:2048 nt lds
    s_waitcnt vmcnt(24)
    buffer_load_dwordx4 v5, s[36:39], s34 offen offset:3072 nt lds
    s_add_u32 m0, m0, s33
    s_add_u32 s34, s34, s85
    s_and_b32 s34, s34, s87
    s_sub_u32 s88, s88, 1
    s_cmp_lg_u32 s88, 0
    s_cbranch_scc1 L_stream2
    s_setpc_b64 s[90:91]
L_stream3:
    s_waitcnt vmcnt(28)
    buffer_load_dwordx4 v2, s[36:39], s34 offen offset:0 nt lds
    s_waitcnt vmcnt(28)
    buffer_load_dwordx4 v3, s[36:39], s34 offen offset:1024 nt lds
    s_waitcnt vmcnt(28)
    buffer_load_dwordx4 v4, s[36:39], s34 offen offset:2048 nt lds
    s_waitcnt vmcnt(28)
    buffer_load_dwordx4 v5, s[36:39], s34 offen offset:3072 nt lds
    s_add_u32 m0, m0, s33
    s_add_u32 s34, s34, s85
    s_and_b32 s34, s34, s87
    s_waitcnt vmcnt(28)
    ds_write_b32 v9, v18 offset:0
    v_add_u32 v18, 1, v18
    buffer_load_dwordx4 v2, s[36:39], s34 offen offset:0 nt lds
    s_waitcnt vmcnt(28)
    buffer_load_dwordx4 v3, s[36:39], s34 offen offset:1024 nt lds
    s_waitcnt vmcnt(28)
    buffer_load_dwordx4 v4, s[36:39], s34 offen offset:2048 nt lds
    s_waitcnt vmcnt(28)
    buffer_load_dwordx4 v5, s[36:39], s34 offen offset:3072 nt lds
    s_add_u32 m0, m0, s33
    s_add_u32 s34, s34, s85
    s_and_b32 s34, s34, s87
    s_sub_u32 s88, s88, 1
    s_cmp_lg_u32 s88, 0
    s_cbranch_scc1 L_stream3
    s_setpc_b64 s[90:91]
L_other:
    s_barrier
    s_waitcnt lgkmcnt(0)
    s_mov_b32 s52, s22
    s_mov_b32 s53, s23
    s_mov_b32 s54, 3080192
    s_mov_b32 s55, 0x20000
    s_cmp_eq_u32 s3, 5
    s_cbranch_scc1 L_aux
    s_load_dword s24, s[22:23], 0
    s_mov_b32 s33, s3
    v_and_b32 v10, 15, v1
    v_lshrrev_b32 v11, 4, v1
    v_xor_b32 v16, v10, v11
    v_lshlrev_b32 v16, 4, v16
    v_lshl_or_b32 v16, v10, 8, v16
    s_lshl_b32 s77, s33, 14
    v_add_u32 v16, s77, v16
    v_xor_b32 v17, 64, v16
    v_xor_b32 v18, 0x80, v16
    v_xor_b32 v19, 0xc0, v16
    v_and_b32 v12, 3, v1
    v_bfe_u32 v13, v1, 2, 2
    v_lshlrev_b32 v20, 8, v12
    v_lshl_or_b32 v20, v11, 4, v20
    v_add_u32 v20, 155648, v20
    v_lshl_add_u32 v21, v12, 4, v9
    s_lshl_b32 s77, s33, 2
    v_add_u32 v22, s77, v21
    v_add_u32 v0, s77, v9
    v_mul_u32_u24 v24, 576, v12
    v_lshl_add_u32 v24, v11, 4, v24
    v_add_u32 v24, 157696, v24
    v_lshrrev_b32 v14, 1, v13
    v_lshl_add_u32 v23, v14, 6, v24
    v_and_b32 v14, 1, v13
    v_lshl_add_u32 v23, v14, 3, v23
    s_lshl_b32 s77, s33, 7
    v_add_u32 v23, s77, v23
    v_lshrrev_b32 v14, 2, v1
    v_and_b32 v15, 7, v14
    v_lshlrev_b32 v15, 1, v15
    v_lshrrev_b32 v25, 1, v12
    s_lshl_b32 s77, s33, 2
    v_or_b32 v25, s77, v25
    v_xor_b32 v25, v25, v15
    v_lshlrev_b32 v25, 4, v25
    v_lshl_or_b32 v25, v14, 8, v25
    v_and_b32 v15, 1, v12
    v_lshl_or_b32 v25, v15, 3, v25
    v_add_u32 v25, 65536, v25
    v_xor_b32 v26, 32, v25
    v_lshrrev_b32 v27, 1, v12
    s_lshl_b32 s77, s33, 1
    v_or_b32 v27, s77, v27
    v_and_b32 v28, 6, v14
    v_xor_b32 v27, v27, v28
    v_lshlrev_b32 v27, 4, v27
    v_lshl_or_b32 v27, v14, 7, v27
    v_lshl_or_b32 v27, v15, 3, v27
    v_add_u32 v27, 131072, v27
    v_mul_u32_u24 v28, 272, v6
    v_lshl_add_u32 v28, v12, 4, v28
    v_bfe_u32 v14, v1, 2, 1
    v_lshl_add_u32 v28, v14, 3, v28
    s_lshl_b32 s77, s33, 6
    s_add_u32 s77, s77, 160768
    v_add_u32 v28, s77, v28
    v_mul_u32_u24 v29, 272, v7
    v_lshl_add_u32 v29, v11, 4, v29
    v_add_u32 v29, 160768, v29
    v_lshlrev_b32 v30, 7, v7
    v_lshl_add_u32 v30, v11, 3, v30
    v_add_u32 v30, 156672, v30
    v_lshlrev_b32 v31, 11, v6
    v_lshl_or_b32 v31, v7, 4, v31
    s_lshl_b32 s89, s26, 16
    s_lshl_b32 s77, s33, 14
    s_add_u32 s89, s89, s77
    s_lshl_b32 s77, s27, 9
    s_add_u32 s89, s89, s77
    s_add_u32 s89, s89, 524288
    s_lshl_b32 s90, s32, 14
    s_lshl_b32 s77, s33, 7
    s_add_u32 s77, s77, s90
    s_lshl_b32 s91, s30, 11
    s_add_u32 s91, s90, s91
    s_lshl_b32 s78, s33, 9
    s_add_u32 s91, s91, s78
    s_add_u32 s91, s91, 1048576
    s_add_u32 s90, s77, 524288
    v_mov_b32 v32, 0
    v_mov_b32 v33, 0
    v_mov_b32 v34, 0
    v_mov_b32 v35, 0
    s_mov_b32 exec_hi, 0
    buffer_store_dwordx4 v[32:35], v8, s[52:55], s89 offen
    s_mov_b32 exec_hi, -1
    v_lshrrev_b32 v14, 5, v1
    s_lshl_b32 s77, s33, 1
    v_add_u32 v15, s77, v14
    v_and_b32 v2, 31, v1
    v_mul_u32_u24 v153, 1040, v15
    v_lshl_add_u32 v153, v2, 4, v153
    v_add_u32 v153, 114688, v153
    v_mul_u32_u24 v154, 1040, v7
    v_lshl_add_u32 v154, v11, 3, v154
    s_lshl_b32 s77, s30, 7
    s_add_u32 s77, s77, 114688
    v_add_u32 v155, s77, v154
    s_lshl_b32 s77, s31, 8
    s_add_u32 s77, s77, 114688
    v_add_u32 v154, s77, v154
    s_lshl_b32 s92, s26, 16
    s_add_u32 s92, s92, 2097152
    s_lshl_b32 s77, s27, 8
    s_add_u32 s77, s77, s92
    v_lshl_add_u32 v156, v7, 13, s77
    s_lshl_b32 s77, s35, 14
    s_lshl_b32 s78, s30, 8
    s_add_u32 s77, s77, s78
    s_add_u32 s77, s77, 2621440
    v_lshl_add_u32 v3, v7, 11, s77
    s_nop 1
    v_mov_b32_dpp v156, v3 quad_perm:[0,1,2,3] row_mask:0xf bank_mask:0xc
    v_lshl_add_u32 v156, v11, 4, v156
    s_lshl_b32 s93, s33, 6
    s_mov_b32 s94, 0x00ff00ff
    s_cmp_lt_u32 s35, 28
    s_cselect_b32 s94, -1, s94
    v_lshlrev_b32 v157, 11, v14
    v_lshl_or_b32 v157, v2, 4, v157
    s_lshl_b32 s77, s28, 13
    s_add_u32 s92, s92, s77
    s_lshl_b32 s77, s33, 9
    s_add_u32 s92, s92, s77
    s_add_u32 s95, s92, 0x1000
    s_lshl_b32 s77, s33, 8
    s_add_u32 s77, s77, 155648
    v_lshl_add_u32 v158, v2, 3, s77
    s_getreg_b32 s87, hwreg(HW_REG_XCC_ID, 0, 3)
    s_waitcnt lgkmcnt(0)
    s_add_u32 s24, s24, 1
    s_and_b32 s25, s24, 15
    s_cselect_b32 s25, 0, 1
    s_add_u32 s24, s24, s25
    s_waitcnt vmcnt(5)
    v_lshlrev_b32 v48, 16, v40
    v_and_b32 v49, 0xffff0000, v40
    v_lshlrev_b32 v50, 16, v41
    v_and_b32 v51, 0xffff0000, v41
    v_lshlrev_b32 v52, 16, v42
    v_and_b32 v53, 0xffff0000, v42
    v_lshlrev_b32 v54, 16, v43
    v_and_b32 v55, 0xffff0000, v43
    v_lshlrev_b32 v56, 16, v44
    v_and_b32 v57, 0xffff0000, v44
    v_lshlrev_b32 v58, 16, v45
    v_and_b32 v59, 0xffff0000, v45
    v_lshlrev_b32 v60, 16, v46
    v_and_b32 v61, 0xffff0000, v46
    v_lshlrev_b32 v62, 16, v47
    v_and_b32 v63, 0xffff0000, v47
    v_add_f32 v64, v48, v56
    v_add_f32 v65, v49, v57
    v_add_f32 v66, v50, v58
    v_add_f32 v67, v51, v59
    v_add_f32 v68, v52, v60
    v_add_f32 v69, v53, v61
    v_add_f32 v70, v54, v62
    v_add_f32 v71, v55, v63
    v_add_f32 v64, v64, v68
    v_add_f32 v65, v65, v69
    v_add_f32 v66, v66, v70
    v_add_f32 v67, v67, v71
    v_add_f32 v64, v64, v65
    v_add_f32 v66, v66, v67
    v_add_f32 v2, v64, v66
    s_nop 1
    v_add_f32_dpp v2, v2, v2 quad_perm:[1,0,3,2] row_mask:0xf bank_mask:0xf
    s_nop 1
    v_add_f32_dpp v2, v2, v2 quad_perm:[2,3,0,1] row_mask:0xf bank_mask:0xf
    s_nop 1
    v_add_f32_dpp v2, v2, v2 row_half_mirror row_mask:0xf bank_mask:0xf
    s_nop 1
    v_add_f32_dpp v2, v2, v2 row_mirror row_mask:0xf bank_mask:0xf
    v_mov_b32 v3, v2
    s_nop 1
    v_permlane16_swap_b32 v2, v3
    v_add_f32 v2, v2, v3
    v_mul_f32 v2, 0xbb000000, v2
    v_add_f32 v64, v48, v2
    v_add_f32 v65, v49, v2
    v_add_f32 v66, v50, v2
    v_add_f32 v67, v51, v2
    v_add_f32 v68, v52, v2
    v_add_f32 v69, v53, v2
    v_add_f32 v70, v54, v2
    v_add_f32 v71, v55, v2
    v_add_f32 v72, v56, v2
    v_add_f32 v73, v57, v2
    v_add_f32 v74, v58, v2
    v_add_f32 v75, v59, v2
    v_add_f32 v76, v60, v2
    v_add_f32 v77, v61, v2
    v_add_f32 v78, v62, v2
    v_add_f32 v79, v63, v2
    v_mul_f32 v4, v64, v64
    v_mul_f32 v5, v65, v65
    v_fmac_f32 v4, v66, v66
    v_fmac_f32 v5, v67, v67
    v_fmac_f32 v4, v68, v68
    v_fmac_f32 v5, v69, v69
    v_fmac_f32 v4, v70, v70
    v_fmac_f32 v5, v71, v71
    v_fmac_f32 v4, v72, v72
    v_fmac_f32 v5, v73, v73
    v_fmac_f32 v4, v74, v74
    v_fmac_f32 v5, v75, v75
    v_fmac_f32 v4, v76, v76
    v_fmac_f32 v5, v77, v77
    v_fmac_f32 v4, v78, v78
    v_fmac_f32 v5, v79, v79
    v_add_f32 v4, v4, v5
    s_nop 1
    v_add_f32_dpp v4, v4, v4 quad_perm:[1,0,3,2] row_mask:0xf bank_mask:0xf
    s_nop 1
    v_add_f32_dpp v4, v4, v4 quad_perm:[2,3,0,1] row_mask:0xf bank_mask:0xf
    s_nop 1
    v_add_f32_dpp v4, v4, v4 row_half_mirror row_mask:0xf bank_mask:0xf
    s_nop 1
    v_add_f32_dpp v4, v4, v4 row_mirror row_mask:0xf bank_mask:0xf
    v_mov_b32 v3, v4
    s_nop 1
    v_permlane16_swap_b32 v4, v3
    v_add_f32 v4, v4, v3
    v_mul_f32 v4, 0x3b000000, v4
    v_cvt_pk_bf16_f32 v3, v2, v4
    v_lshlrev_b32 v2, 16, v3
    v_and_b32 v3, 0xffff0000, v3
    v_add_f32 v3, 0x3727c5ac, v3
    v_cvt_pk_bf16_f32 v3, v3, v3
    v_lshlrev_b32 v3, 16, v3
    v_sqrt_f32 v3, v3
    v_add_f32 v48, v48, v2
    v_add_f32 v49, v49, v2
    v_add_f32 v50, v50, v2
    v_add_f32 v51, v51, v2
    v_add_f32 v52, v52, v2
    v_add_f32 v53, v53, v2
    v_add_f32 v54, v54, v2
    v_add_f32 v55, v55, v2
    v_add_f32 v56, v56, v2
    v_add_f32 v57, v57, v2
    v_add_f32 v58, v58, v2
    v_add_f32 v59, v59, v2
    v_add_f32 v60, v60, v2
    v_add_f32 v61, v61, v2
    v_add_f32 v62, v62, v2
    v_add_f32 v63, v63, v2
    v_cvt_pk_bf16_f32 v3, v3, v3
    v_lshlrev_b32 v3, 16, v3
    v_rcp_f32 v3, v3
    v_cvt_pk_bf16_f32 v40, v48, v49
    v_cvt_pk_bf16_f32 v41, v50, v51
    v_cvt_pk_bf16_f32 v42, v52, v53
    v_cvt_pk_bf16_f32 v43, v54, v55
    v_cvt_pk_bf16_f32 v44, v56, v57
    v_cvt_pk_bf16_f32 v45, v58, v59
    v_cvt_pk_bf16_f32 v46, v60, v61
    v_cvt_pk_bf16_f32 v47, v62, v63
    v_lshlrev_b32 v48, 16, v40
    v_and_b32 v49, 0xffff0000, v40
    v_lshlrev_b32 v50, 16, v41
    v_and_b32 v51, 0xffff0000, v41
    v_lshlrev_b32 v52, 16, v42
    v_and_b32 v53, 0xffff0000, v42
    v_lshlrev_b32 v54, 16, v43
    v_and_b32 v55, 0xffff0000, v43
    v_lshlrev_b32 v56, 16, v44
    v_and_b32 v57, 0xffff0000, v44
    v_lshlrev_b32 v58, 16, v45
    v_and_b32 v59, 0xffff0000, v45
    v_lshlrev_b32 v60, 16, v46
    v_and_b32 v61, 0xffff0000, v46
    v_lshlrev_b32 v62, 16, v47
    v_and_b32 v63, 0xffff0000, v47
    v_mul_f32 v48, v48, v3
    v_mul_f32 v49, v49, v3
    v_mul_f32 v50, v50, v3
    v_mul_f32 v51, v51, v3
    v_mul_f32 v52, v52, v3
    v_mul_f32 v53, v53, v3
    v_mul_f32 v54, v54, v3
    v_mul_f32 v55, v55, v3
    v_mul_f32 v56, v56, v3
    v_mul_f32 v57, v57, v3
    v_mul_f32 v58, v58, v3
    v_mul_f32 v59, v59, v3
    v_mul_f32 v60, v60, v3
    v_mul_f32 v61, v61, v3
    v_mul_f32 v62, v62, v3
    v_mul_f32 v63, v63, v3
    v_cvt_pk_bf16_f32 v40, v48, v49
    v_cvt_pk_bf16_f32 v41, v50, v51
    v_cvt_pk_bf16_f32 v42, v52, v53
    v_cvt_pk_bf16_f32 v43, v54, v55
    v_cvt_pk_bf16_f32 v44, v56, v57
    v_cvt_pk_bf16_f32 v45, v58, v59
    v_cvt_pk_bf16_f32 v46, v60, v61
    v_cvt_pk_bf16_f32 v47, v62, v63
    v_mov_b32 v4, 1
    ds_write_b128 v153, v[40:43]
    ds_write_b128 v153, v[44:47] offset:512
    s_waitcnt vmcnt(1)
    ds_write_b32 v0, v4 offset:16
L_w4_5:
    s_sub_u32 s83, s83, 1
    s_cbranch_scc1 L_out
    ds_read_b128 v[36:39], v9 offset:16
    s_waitcnt lgkmcnt(0)
    v_min3_u32 v2, v36, v37, v38
    v_min_u32 v2, v2, v39
    v_cmp_eq_u32 vcc, 0, v2
    s_cbranch_vccnz L_w4_5
    ds_read2_b64 v[64:67], v155 offset0:0 offset1:4
    ds_read2_b64 v[68:71], v155 offset0:8 offset1:12
    ds_read2_b64 v[72:75], v154 offset0:0 offset1:4
    ds_read2_b64 v[76:79], v154 offset0:8 offset1:12
    ds_read2_b64 v[80:83], v154 offset0:16 offset1:20
    ds_read2_b64 v[84:87], v154 offset0:24 offset1:28
L_wf_6:
    s_sub_u32 s83, s83, 1
    s_cbranch_scc1 L_out
    ds_read_b32 v2, v9 offset:0
    s_waitcnt lgkmcnt(0)
    v_readfirstlane_b32 s79, v2
    s_nop 0
    s_cmp_lt_i32 s79, 1
    s_cbranch_scc1 L_wf_6
    ds_read_b32 v5, v9 offset:8
    ds_read_b64_tr_b16 v[104:105], v27 offset:16384
    ds_read_b64_tr_b16 v[106:107], v27 offset:18432
    ds_read_b64_tr_b16 v[108:109], v27 offset:20480
    ds_read_b64_tr_b16 v[110:111], v27 offset:22528
    ds_read_b64_tr_b16 v[88:89], v27 offset:0
    ds_read_b64_tr_b16 v[90:91], v27 offset:2048
    ds_read_b64_tr_b16 v[92:93], v27 offset:4096
    ds_read_b64_tr_b16 v[94:95], v27 offset:6144
    ds_read_b64_tr_b16 v[96:97], v27 offset:8192
    ds_read_b64_tr_b16 v[98:99], v27 offset:10240
    ds_read_b64_tr_b16 v[100:101], v27 offset:12288
    ds_read_b64_tr_b16 v[102:103], v27 offset:14336
    s_waitcnt lgkmcnt(8)
    v_mfma_f32_16x16x32_bf16 v[136:139], v[104:107], v[64:67], 0
    v_mfma_f32_16x16x32_bf16 v[136:139], v[108:111], v[68:71], v[136:139]
    s_waitcnt lgkmcnt(6)
    v_mfma_f32_16x16x32_bf16 v[132:135], v[88:91], v[72:75], 0
    s_waitcnt lgkmcnt(4)
    v_mfma_f32_16x16x32_bf16 v[132:135], v[92:95], v[76:79], v[132:135]
    s_waitcnt lgkmcnt(2)
    v_mfma_f32_16x16x32_bf16 v[132:135], v[96:99], v[80:83], v[132:135]
    s_waitcnt lgkmcnt(0)
    v_mfma_f32_16x16x32_bf16 v[132:135], v[100:103], v[84:87], v[132:135]
    ds_write_b32 v0, v4 offset:32
    v_bfi_b32 v139, 15, s24, v139
    v_or_b32 v5, s87, v5
    s_nop 4
    v_bfi_b32 v135, 15, v5, v135
    v_mov_b32_dpp v132, v136 quad_perm:[0,1,2,3] row_mask:0xf bank_mask:0xc
    v_mov_b32_dpp v133, v137 quad_perm:[0,1,2,3] row_mask:0xf bank_mask:0xc
    v_mov_b32_dpp v134, v138 quad_perm:[0,1,2,3] row_mask:0xf bank_mask:0xc
    v_mov_b32_dpp v135, v139 quad_perm:[0,1,2,3] row_mask:0xf bank_mask:0xc
    v_bfi_b32 v132, 15, s24, v132
    v_bfi_b32 v133, 15, s24, v133
    v_bfi_b32 v134, 15, s24, v134
    s_mov_b32 exec_lo, s94
    s_mov_b32 exec_hi, s94
    buffer_store_dwordx4 v[132:135], v156, s[52:55], s93 offen
    s_mov_b64 exec, -1
    s_mov_b32 s74, 0xffff
    s_mov_b32 s75, 0xffff
    s_mov_b32 s80, 0x20080
    s_mov_b32 s93, 0
    s_sleep 8
    buffer_load_dwordx4 v[36:39], v157, s[52:55], s92 offen offset:0 sc1
    buffer_load_dwordx4 v[40:43], v157, s[52:55], s95 offen offset:0 sc1
    s_branch L_gw_8
L_gr_7:
    v_and_b32 v2, 15, v2
    v_and_b32 v3, 15, v3
    v_cmp_ne_u32 s[60:61], 0, v2
    v_cmp_ne_u32 s[62:63], 0, v3
    s_sub_u32 s83, s83, 1
    s_cbranch_scc1 L_out
    s_add_u32 s93, s93, 1
    s_cmp_lt_u32 s93, 6
    s_cbranch_scc1 L_qt_9
    buffer_wbl2 sc1
    s_waitcnt vmcnt(0)
    buffer_inv sc1
L_qt_9:
    s_wqm_b64 exec, s[60:61]
    buffer_load_dwordx4 v[36:39], v157, s[52:55], s92 offen offset:0 sc1
    s_wqm_b64 exec, s[62:63]
    buffer_load_dwordx4 v[40:43], v157, s[52:55], s95 offen offset:0 sc1
    s_mov_b64 exec, -1
    s_waitcnt vmcnt(0)
L_gw_8:
    s_waitcnt vmcnt(1)
    v_bitop3_b32 v2, v36, v37, s24 bitop3:0x7e
    v_bitop3_b32 v2, v2, v38, s24 bitop3:0xf6
    s_waitcnt vmcnt(0)
    v_bitop3_b32 v3, v40, v41, s24 bitop3:0x7e
    v_bitop3_b32 v3, v3, v42, s24 bitop3:0xf6
    v_bitop3_b32 v5, v2, v3, 15 bitop3:0xa8
    v_cmp_ne_u32 vcc, 0, v5
    s_cbranch_vccnz L_gr_7
    v_bitop3_b32 v2, v39, v43, s87 bitop3:0x7e
    v_and_b32 v3, 8, v39
    v_and_b32 v5, 8, v43
    v_and_b32 v2, 7, v2
    v_cmp_ne_u32 vcc, 0, v2
    v_cmp_ne_u32 s[60:61], 0, v3
    v_cmp_ne_u32 s[62:63], 0, v5
    v_bfi_b32 v36, 15, 8, v36
    v_bfi_b32 v37, 15, 8, v37
    v_bfi_b32 v38, 15, 8, v38
    v_bfi_b32 v39, 15, 8, v39
    v_bfi_b32 v40, 15, 8, v40
    v_bfi_b32 v41, 15, 8, v41
    v_bfi_b32 v42, 15, 8, v42
    v_bfi_b32 v43, 15, 8, v43
    v_add_f32 v36, v36, v40
    v_add_f32 v37, v37, v41
    v_add_f32 v38, v38, v42
    v_add_f32 v39, v39, v43
    v_mov_b32 v40, v36
    v_mov_b32 v41, v37
    v_mov_b32 v42, v38
    v_mov_b32 v43, v39
    v_permlane32_swap_b32 v36, v40
    v_permlane32_swap_b32 v37, v41
    v_permlane32_swap_b32 v38, v42
    v_permlane32_swap_b32 v39, v43
    v_add_f32 v36, v36, v40
    v_add_f32 v37, v37, v41
    v_add_f32 v38, v38, v42
    v_add_f32 v39, v39, v43
    s_cmp_eq_u64 vcc, 0
    s_cselect_b32 s97, 0x10080, s80
    s_and_b64 s[64:65], s[60:61], s[74:75]
    s_andn2_b64 s[60:61], s[60:61], s[74:75]
    s_and_b64 s[66:67], s[62:63], s[74:75]
    s_andn2_b64 s[62:63], s[62:63], s[74:75]
    s_bcnt1_i32_b64 s64, s[64:65]
    s_bcnt1_i32_b64 s66, s[66:67]
    s_bcnt1_i32_b64 s60, s[60:61]
    s_bcnt1_i32_b64 s62, s[62:63]
    s_add_u32 s97, s97, s64
    s_add_u32 s97, s97, s66
    s_sub_u32 s97, s97, s60
    s_sub_u32 s97, s97, s62
    v_cvt_pk_bf16_f32 v40, v36, v37
    v_cvt_pk_bf16_f32 v41, v38, v39
    v_mov_b32 v4, s97
    ds_write_b64 v158, v[40:41]
    ds_write_b32 v0, v4 offset:48
    s_lshl1_add_u32 s34, s33, 3
L_wf_10:
    s_sub_u32 s83, s83, 1
    s_cbranch_scc1 L_out
    s_sleep 1
    ds_read_b32 v2, v9 offset:0
    s_waitcnt lgkmcnt(0)
    v_readfirstlane_b32 s79, v2
    s_nop 0
    s_cmp_lt_i32 s79, s34
    s_cbranch_scc1 L_wf_10
    ds_read_b128 v[32:35], v16 offset:0
    ds_read_b128 v[36:39], v17 offset:0
    ds_read_b128 v[40:43], v18 offset:0
    ds_read_b128 v[44:47], v19 offset:0
    ds_read_b128 v[48:51], v16 offset:4096
    ds_read_b128 v[52:55], v17 offset:4096
    ds_read_b128 v[56:59], v18 offset:4096
    ds_read_b128 v[60:63], v19 offset:4096
    ds_read_b128 v[64:67], v16 offset:8192
    ds_read_b128 v[68:71], v17 offset:8192
    ds_read_b128 v[72:75], v18 offset:8192
    ds_read_b128 v[76:79], v19 offset:8192
    ds_read_b128 v[80:83], v16 offset:12288
    ds_read_b128 v[84:87], v17 offset:12288
    ds_read_b128 v[88:91], v18 offset:12288
    ds_read_b128 v[92:95], v19 offset:12288
L_w4_11:
    s_sub_u32 s83, s83, 1
    s_cbranch_scc1 L_out
    ds_read_b128 v[96:99], v9 offset:48
    s_waitcnt lgkmcnt(0)
    v_min3_u32 v2, v96, v97, v98
    v_min_u32 v2, v2, v99
    v_cmp_eq_u32 vcc, 0, v2
    s_cbranch_vccnz L_w4_11
    v_max3_u32 v2, v96, v97, v98
    v_max_u32 v2, v2, v99
    v_add3_u32 v96, v96, v97, v98
    v_add_u32 v96, v96, v99
    v_readfirstlane_b32 s97, v2
    v_readfirstlane_b32 s81, v96
    s_lshr_b32 s97, s97, 16
    s_and_b32 s81, s81, 0xffff
    s_cmp_gt_u32 s81, 512
    s_cselect_b32 s81, 0, 4
    s_xor_b32 s81, s81, s26
    s_bitcmp1_b32 s81, 2
    s_cselect_b32 s81, 532480, 0
    s_xor_b32 s91, s91, s81
    s_xor_b32 s88, s91, 532480
    ds_read_b128 v[96:99], v20 offset:0
    ds_read_b128 v[100:103], v20 offset:64
    ds_read_b128 v[104:107], v20 offset:128
    ds_read_b128 v[108:111], v20 offset:192
    s_cmp_eq_u32 s97, 1
    s_cbranch_scc1 L_nofl
    buffer_wbl2 sc1
L_nofl:
    s_waitcnt lgkmcnt(3)
    v_mfma_f32_16x16x32_bf16 v[112:115], v[32:35], v[96:99], 0
    v_mfma_f32_16x16x32_bf16 v[116:119], v[48:51], v[96:99], 0
    v_mfma_f32_16x16x32_bf16 v[120:123], v[64:67], v[96:99], 0
    v_mfma_f32_16x16x32_bf16 v[124:127], v[80:83], v[96:99], 0
    s_waitcnt lgkmcnt(2)
    v_mfma_f32_16x16x32_bf16 v[112:115], v[36:39], v[100:103], v[112:115]
    v_mfma_f32_16x16x32_bf16 v[116:119], v[52:55], v[100:103], v[116:119]
    v_mfma_f32_16x16x32_bf16 v[120:123], v[68:71], v[100:103], v[120:123]
    v_mfma_f32_16x16x32_bf16 v[124:127], v[84:87], v[100:103], v[124:127]
    s_waitcnt lgkmcnt(1)
    v_mfma_f32_16x16x32_bf16 v[112:115], v[40:43], v[104:107], v[112:115]
    v_mfma_f32_16x16x32_bf16 v[116:119], v[56:59], v[104:107], v[116:119]
    v_mfma_f32_16x16x32_bf16 v[120:123], v[72:75], v[104:107], v[120:123]
    v_mfma_f32_16x16x32_bf16 v[124:127], v[88:91], v[104:107], v[124:127]
    s_waitcnt lgkmcnt(0)
    v_mfma_f32_16x16x32_bf16 v[112:115], v[44:47], v[108:111], v[112:115]
    v_mfma_f32_16x16x32_bf16 v[116:119], v[60:63], v[108:111], v[116:119]
    v_mfma_f32_16x16x32_bf16 v[120:123], v[76:79], v[108:111], v[120:123]
    v_mfma_f32_16x16x32_bf16 v[124:127], v[92:95], v[108:111], v[124:127]
    s_nop 5
    v_mov_b32_dpp v112, v116 quad_perm:[0,1,2,3] row_mask:0xf bank_mask:0x2
    v_mov_b32_dpp v113, v117 quad_perm:[0,1,2,3] row_mask:0xf bank_mask:0x2
    v_mov_b32_dpp v114, v118 quad_perm:[0,1,2,3] row_mask:0xf bank_mask:0x2
    v_mov_b32_dpp v115, v119 quad_perm:[0,1,2,3] row_mask:0xf bank_mask:0x2
    v_mov_b32_dpp v112, v120 quad_perm:[0,1,2,3] row_mask:0xf bank_mask:0x4
    v_mov_b32_dpp v113, v121 quad_perm:[0,1,2,3] row_mask:0xf bank_mask:0x4
    v_mov_b32_dpp v114, v122 quad_perm:[0,1,2,3] row_mask:0xf bank_mask:0x4
    v_mov_b32_dpp v115, v123 quad_perm:[0,1,2,3] row_mask:0xf bank_mask:0x4
    v_mov_b32_dpp v112, v124 quad_perm:[0,1,2,3] row_mask:0xf bank_mask:0x8
    v_mov_b32_dpp v113, v125 quad_perm:[0,1,2,3] row_mask:0xf bank_mask:0x8
    v_mov_b32_dpp v114, v126 quad_perm:[0,1,2,3] row_mask:0xf bank_mask:0x8
    v_mov_b32_dpp v115, v127 quad_perm:[0,1,2,3] row_mask:0xf bank_mask:0x8
    v_cvt_pk_bf16_f32 v2, v112, v113
    v_cvt_pk_bf16_f32 v3, v114, v115
    v_lshlrev_b32 v112, 16, v2
    v_and_b32 v113, 0xffff0000, v2
    v_lshlrev_b32 v114, 16, v3
    v_and_b32 v115, 0xffff0000, v3
    v_mul_f32 v112, 0x3db504f3, v112
    v_mul_f32 v113, 0x3db504f3, v113
    v_mul_f32 v114, 0x3db504f3, v114
    v_mul_f32 v115, 0x3db504f3, v115
    v_cvt_pk_bf16_f32 v2, v112, v113
    v_cvt_pk_bf16_f32 v3, v114, v115
    v_lshlrev_b32 v112, 16, v2
    v_and_b32 v113, 0xffff0000, v2
    v_lshlrev_b32 v114, 16, v3
    v_and_b32 v115, 0xffff0000, v3
    v_max3_f32 v4, v112, v113, v114
    v_max_f32 v4, v4, v115
    s_nop 1
    v_max_f32_dpp v4, v4, v4 row_ror:4 row_mask:0xf bank_mask:0xf
    s_nop 1
    v_max_f32_dpp v4, v4, v4 row_ror:8 row_mask:0xf bank_mask:0xf
    v_mov_b32 v2, v4
    s_nop 1
    v_permlane16_swap_b32 v4, v2
    v_max_f32 v4, v4, v2
    v_mov_b32 v2, v4
    s_nop 1
    v_permlane32_swap_b32 v4, v2
    v_max_f32 v4, v4, v2
    ds_write_b32 v22, v4 offset:64
L_s4_12:
    s_sub_u32 s83, s83, 1
    s_cbranch_scc1 L_out
    ds_read_b128 v[96:99], v21 offset:64
    s_waitcnt lgkmcnt(0)
    v_max3_u32 v2, v96, v97, v98
    v_max_u32 v2, v2, v99
    v_cmp_eq_u32 vcc, -1, v2
    s_cbranch_vccnz L_s4_12
    v_max3_f32 v4, v96, v97, v98
    v_max_f32 v4, v4, v99
    v_sub_f32 v112, v112, v4
    v_sub_f32 v113, v113, v4
    v_sub_f32 v114, v114, v4
    v_sub_f32 v115, v115, v4
    v_mul_f32 v112, 0x3fb8aa3b, v112
    v_mul_f32 v113, 0x3fb8aa3b, v113
    v_mul_f32 v114, 0x3fb8aa3b, v114
    v_mul_f32 v115, 0x3fb8aa3b, v115
    v_exp_f32 v112, v112
    v_exp_f32 v113, v113
    v_exp_f32 v114, v114
    v_exp_f32 v115, v115
    v_cvt_pk_bf16_f32 v2, v112, v113
    v_cvt_pk_bf16_f32 v3, v114, v115
    ds_write_b64 v23, v[2:3]
    v_add_f32 v5, v112, v113
    v_add_f32 v114, v114, v115
    v_add_f32 v5, v5, v114
    s_nop 1
    v_add_f32_dpp v5, v5, v5 row_ror:4 row_mask:0xf bank_mask:0xf
    s_nop 1
    v_add_f32_dpp v5, v5, v5 row_ror:8 row_mask:0xf bank_mask:0xf
    v_mov_b32 v112, v5
    s_nop 1
    v_permlane16_swap_b32 v5, v112
    v_add_f32 v5, v5, v112
    v_mov_b32 v112, v5
    s_nop 1
    v_permlane32_swap_b32 v5, v112
    v_add_f32 v5, v5, v112
    ds_write_b32 v22, v5 offset:128
L_s4_13:
    s_sub_u32 s83, s83, 1
    s_cbranch_scc1 L_out
    ds_read_b128 v[96:99], v21 offset:128
    s_waitcnt lgkmcnt(0)
    v_max3_u32 v2, v96, v97, v98
    v_max_u32 v2, v2, v99
    v_cmp_eq_u32 vcc, -1, v2
    s_cbranch_vccnz L_s4_13
    v_add_f32 v96, v96, v97
    v_add_f32 v98, v98, v99
    v_add_f32 v96, v96, v98
    v_log_f32 v130, v96
    v_rcp_f32 v5, v96
    v_mov_b32 v2, 0x3fb8aa3b
    v_fmac_f32 v130, v4, v2
    v_mov_b32 v131, s24
    v_mov_b32 v132, 0
    v_mov_b32 v133, 0
    v_mov_b32 v134, 0
    v_mov_b32 v135, 0
    v_mov_b32 v136, 0
    v_mov_b32 v137, 0
    v_mov_b32 v138, 0
    v_mov_b32 v139, 0
    s_mov_b32 s34, 10
L_pv:
    s_sub_u32 s83, s83, 1
    s_cbranch_scc1 L_out
    ds_read_b32 v2, v9 offset:0
    ds_read_b64_tr_b16 v[140:141], v25
    ds_read_b64_tr_b16 v[142:143], v25 offset:4096
    ds_read_b128 v[148:151], v24
    ds_read_b64_tr_b16 v[144:145], v26
    ds_read_b64_tr_b16 v[146:147], v26 offset:4096
    s_waitcnt lgkmcnt(5)
    v_readfirstlane_b32 s79, v2
    s_nop 0
    s_cmp_lt_i32 s79, s34
    s_waitcnt lgkmcnt(0)
    s_cbranch_scc1 L_pv
    v_mfma_f32_16x16x32_bf16 v[132:135], v[148:151], v[140:143], v[132:135]
    v_mfma_f32_16x16x32_bf16 v[136:139], v[148:151], v[144:147], v[136:139]
    v_add_u32 v25, 0x2000, v25
    v_add_u32 v26, 0x2000, v26
    v_add_u32 v24, 64, v24
    s_add_u32 s34, s34, 1
    s_cmp_lt_u32 s34, 18
    s_cbranch_scc1 L_pv
    s_nop 0
    v_mul_f32_dpp v140, v5, v132 quad_perm:[0,0,0,0] row_mask:0x1 bank_mask:0xf
    v_mul_f32_dpp v141, v5, v133 quad_perm:[1,1,1,1] row_mask:0x1 bank_mask:0xf
    v_mul_f32_dpp v142, v5, v134 quad_perm:[2,2,2,2] row_mask:0x1 bank_mask:0xf
    v_mul_f32_dpp v143, v5, v135 quad_perm:[3,3,3,3] row_mask:0x1 bank_mask:0xf
    v_mul_f32_dpp v140, v5, v136 quad_perm:[0,0,0,0] row_mask:0x2 bank_mask:0xf
    v_mul_f32_dpp v141, v5, v137 quad_perm:[1,1,1,1] row_mask:0x2 bank_mask:0xf
    v_mul_f32_dpp v142, v5, v138 quad_perm:[2,2,2,2] row_mask:0x2 bank_mask:0xf
    v_mul_f32_dpp v143, v5, v139 quad_perm:[3,3,3,3] row_mask:0x2 bank_mask:0xf
    v_cvt_pk_bf16_f32 v128, v140, v141
    v_cvt_pk_bf16_f32 v129, v142, v143
    s_mov_b32 exec_hi, 0
    s_cmp_eq_u32 s97, 1
    s_cbranch_scc0 L_sd_14
    buffer_store_dwordx4 v[128:131], v8, s[52:55], s89 offen
    s_branch L_sd_15
L_sd_14:
    buffer_store_dwordx4 v[128:131], v8, s[52:55], s89 offen sc1
L_sd_15:
    s_mov_b32 exec_hi, -1
L_wf_16:
    s_sub_u32 s83, s83, 1
    s_cbranch_scc1 L_out
    ds_read_b32 v2, v9 offset:4
    s_waitcnt lgkmcnt(0)
    v_readfirstlane_b32 s79, v2
    s_nop 0
    s_cmp_lt_i32 s79, 1
    s_cbranch_scc1 L_wf_16
    ds_read2_b64 v[64:67], v30 offset0:0 offset1:4
    ds_read2_b64 v[68:71], v30 offset0:8 offset1:12
L_wf_17:
    s_sub_u32 s83, s83, 1
    s_cbranch_scc1 L_out
    ds_read_b32 v2, v9 offset:0
    s_waitcnt lgkmcnt(0)
    v_readfirstlane_b32 s79, v2
    s_nop 0
    s_cmp_lt_i32 s79, 18
    s_cbranch_scc1 L_wf_17
    buffer_load_dwordx4 v[32:35], v31, s[52:55], s90 offen offset:0 sc1
    buffer_load_dwordx4 v[36:39], v31, s[52:55], s90 offen offset:512 sc1
    buffer_load_dwordx4 v[40:43], v31, s[52:55], s90 offen offset:1024 sc1
    buffer_load_dwordx4 v[44:47], v31, s[52:55], s90 offen offset:1536 sc1
    s_waitcnt vmcnt(3)
    v_cmp_ne_u32 s[60:61], s24, v35
    v_lshlrev_b32 v48, 16, v32
    v_and_b32 v49, 0xffff0000, v32
    v_lshlrev_b32 v50, 16, v33
    v_and_b32 v51, 0xffff0000, v33
    s_waitcnt vmcnt(2)
    v_cmp_ne_u32 s[62:63], s24, v39
    v_lshlrev_b32 v52, 16, v36
    v_and_b32 v53, 0xffff0000, v36
    v_lshlrev_b32 v54, 16, v37
    v_and_b32 v55, 0xffff0000, v37
    s_waitcnt vmcnt(1)
    v_cmp_ne_u32 s[64:65], s24, v43
    v_lshlrev_b32 v56, 16, v40
    v_and_b32 v57, 0xffff0000, v40
    v_lshlrev_b32 v58, 16, v41
    v_and_b32 v59, 0xffff0000, v41
    s_waitcnt vmcnt(0)
    v_cmp_ne_u32 s[66:67], s24, v47
    s_or_b64 s[76:77], s[60:61], s[62:63]
    s_or_b64 s[76:77], s[76:77], s[64:65]
    s_or_b64 s[76:77], s[76:77], s[66:67]
    s_cbranch_scc1 L_og_retry
L_og_ok:
    ds_read_b32 v2, v9 offset:0
    v_max3_f32 v12, v34, v38, v42
    v_max_f32 v12, v12, v46
    v_sub_f32 v34, v34, v12
    v_sub_f32 v38, v38, v12
    v_sub_f32 v42, v42, v12
    v_sub_f32 v46, v46, v12
    v_exp_f32 v34, v34
    v_exp_f32 v38, v38
    v_exp_f32 v42, v42
    v_exp_f32 v46, v46
    v_lshlrev_b32 v60, 16, v44
    v_and_b32 v61, 0xffff0000, v44
    v_lshlrev_b32 v62, 16, v45
    v_and_b32 v63, 0xffff0000, v45
    v_add_f32 v12, v34, v38
    v_add_f32 v10, v42, v46
    v_add_f32 v12, v12, v10
    v_rcp_f32 v12, v12
    v_mul_f32_dpp v48, v34, v48 quad_perm:[0,0,0,0] row_mask:0xf bank_mask:0xf
    v_mul_f32_dpp v49, v34, v49 quad_perm:[1,1,1,1] row_mask:0xf bank_mask:0xf
    v_mul_f32_dpp v50, v34, v50 quad_perm:[2,2,2,2] row_mask:0xf bank_mask:0xf
    v_mul_f32_dpp v51, v34, v51 quad_perm:[3,3,3,3] row_mask:0xf bank_mask:0xf
    v_fmac_f32_dpp v48, v38, v52 quad_perm:[0,0,0,0] row_mask:0xf bank_mask:0xf
    v_fmac_f32_dpp v49, v38, v53 quad_perm:[1,1,1,1] row_mask:0xf bank_mask:0xf
    v_fmac_f32_dpp v50, v38, v54 quad_perm:[2,2,2,2] row_mask:0xf bank_mask:0xf
    v_fmac_f32_dpp v51, v38, v55 quad_perm:[3,3,3,3] row_mask:0xf bank_mask:0xf
    v_fmac_f32_dpp v48, v42, v56 quad_perm:[0,0,0,0] row_mask:0xf bank_mask:0xf
    v_fmac_f32_dpp v49, v42, v57 quad_perm:[1,1,1,1] row_mask:0xf bank_mask:0xf
    v_fmac_f32_dpp v50, v42, v58 quad_perm:[2,2,2,2] row_mask:0xf bank_mask:0xf
    v_fmac_f32_dpp v51, v42, v59 quad_perm:[3,3,3,3] row_mask:0xf bank_mask:0xf
    v_fmac_f32_dpp v48, v46, v60 quad_perm:[0,0,0,0] row_mask:0xf bank_mask:0xf
    v_fmac_f32_dpp v49, v46, v61 quad_perm:[1,1,1,1] row_mask:0xf bank_mask:0xf
    v_fmac_f32_dpp v50, v46, v62 quad_perm:[2,2,2,2] row_mask:0xf bank_mask:0xf
    v_fmac_f32_dpp v51, v46, v63 quad_perm:[3,3,3,3] row_mask:0xf bank_mask:0xf
    v_mul_f32_dpp v48, v12, v48 quad_perm:[0,0,0,0] row_mask:0xf bank_mask:0xf
    v_mul_f32_dpp v49, v12, v49 quad_perm:[1,1,1,1] row_mask:0xf bank_mask:0xf
    v_mul_f32_dpp v50, v12, v50 quad_perm:[2,2,2,2] row_mask:0xf bank_mask:0xf
    v_mul_f32_dpp v51, v12, v51 quad_perm:[3,3,3,3] row_mask:0xf bank_mask:0xf
    v_cvt_pk_bf16_f32 v52, v48, v49
    v_cvt_pk_bf16_f32 v53, v50, v51
    ds_write_b64 v28, v[52:53]
    ds_read_b64_tr_b16 v[104:105], v27 offset:16384
    ds_read_b64_tr_b16 v[106:107], v27 offset:18432
    ds_read_b64_tr_b16 v[108:109], v27 offset:20480
    ds_read_b64_tr_b16 v[110:111], v27 offset:22528
    ds_read_b64_tr_b16 v[88:89], v27 offset:0
    ds_read_b64_tr_b16 v[90:91], v27 offset:2048
    ds_read_b64_tr_b16 v[92:93], v27 offset:4096
    ds_read_b64_tr_b16 v[94:95], v27 offset:6144
    ds_read_b64_tr_b16 v[96:97], v27 offset:8192
    ds_read_b64_tr_b16 v[98:99], v27 offset:10240
    ds_read_b64_tr_b16 v[100:101], v27 offset:12288
    ds_read_b64_tr_b16 v[102:103], v27 offset:14336
    s_waitcnt lgkmcnt(12)
    v_readfirstlane_b32 s79, v2
    s_barrier
    s_cmp_lt_i32 s79, 20
    s_cbranch_scc1 L_w_redo
L_w_ok:
    ds_read_b128 v[72:75], v29 offset:0
    ds_read_b128 v[76:79], v29 offset:64
    ds_read_b128 v[80:83], v29 offset:128
    ds_read_b128 v[84:87], v29 offset:192
    s_waitcnt lgkmcnt(4)
    v_mfma_f32_16x16x32_bf16 v[132:135], v[64:67], v[104:107], 0
    v_mfma_f32_16x16x32_bf16 v[132:135], v[68:71], v[108:111], v[132:135]
    s_waitcnt lgkmcnt(3)
    v_mfma_f32_16x16x32_bf16 v[132:135], v[72:75], v[88:91], v[132:135]
    s_waitcnt lgkmcnt(2)
    v_mfma_f32_16x16x32_bf16 v[132:135], v[76:79], v[92:95], v[132:135]
    s_waitcnt lgkmcnt(1)
    v_mfma_f32_16x16x32_bf16 v[132:135], v[80:83], v[96:99], v[132:135]
    s_waitcnt lgkmcnt(0)
    v_mfma_f32_16x16x32_bf16 v[132:135], v[84:87], v[100:103], v[132:135]
    s_mov_b32 exec_hi, 0
    s_nop 6
    v_bfi_b32 v132, 15, s24, v132
    v_bfi_b32 v133, 15, s24, v133
    v_bfi_b32 v134, 15, s24, v134
    v_bfi_b32 v135, 15, s24, v135
    buffer_store_dwordx4 v[132:135], v8, s[52:55], s91 offen sc1
    buffer_store_dwordx4 v[132:135], v8, s[52:55], s88 offen sc1
    s_endpgm
L_og_retry:
    s_sub_u32 s83, s83, 1
    s_cbranch_scc1 L_out
    s_mov_b64 exec, s[60:61]
    buffer_load_dwordx4 v[32:35], v31, s[52:55], s90 offen offset:0 sc1
    s_mov_b64 exec, s[62:63]
    buffer_load_dwordx4 v[36:39], v31, s[52:55], s90 offen offset:512 sc1
    s_mov_b64 exec, s[64:65]
    buffer_load_dwordx4 v[40:43], v31, s[52:55], s90 offen offset:1024 sc1
    s_mov_b64 exec, s[66:67]
    buffer_load_dwordx4 v[44:47], v31, s[52:55], s90 offen offset:1536 sc1
    s_mov_b64 exec, -1
    s_waitcnt vmcnt(0)
    v_cmp_ne_u32 s[60:61], s24, v35
    v_cmp_ne_u32 s[62:63], s24, v39
    v_cmp_ne_u32 s[64:65], s24, v43
    v_cmp_ne_u32 s[66:67], s24, v47
    s_or_b64 s[76:77], s[60:61], s[62:63]
    s_or_b64 s[76:77], s[76:77], s[64:65]
    s_or_b64 s[76:77], s[76:77], s[66:67]
    s_cbranch_scc1 L_og_retry
    v_lshlrev_b32 v48, 16, v32
    v_and_b32 v49, 0xffff0000, v32
    v_lshlrev_b32 v50, 16, v33
    v_and_b32 v51, 0xffff0000, v33
    v_lshlrev_b32 v52, 16, v36
    v_and_b32 v53, 0xffff0000, v36
    v_lshlrev_b32 v54, 16, v37
    v_and_b32 v55, 0xffff0000, v37
    v_lshlrev_b32 v56, 16, v40
    v_and_b32 v57, 0xffff0000, v40
    v_lshlrev_b32 v58, 16, v41
    v_and_b32 v59, 0xffff0000, v41
    s_branch L_og_ok
L_w_redo:
    s_waitcnt lgkmcnt(0)
    ds_read_b64_tr_b16 v[104:105], v27 offset:16384
    ds_read_b64_tr_b16 v[106:107], v27 offset:18432
    ds_read_b64_tr_b16 v[108:109], v27 offset:20480
    ds_read_b64_tr_b16 v[110:111], v27 offset:22528
    ds_read_b64_tr_b16 v[88:89], v27 offset:0
    ds_read_b64_tr_b16 v[90:91], v27 offset:2048
    ds_read_b64_tr_b16 v[92:93], v27 offset:4096
    ds_read_b64_tr_b16 v[94:95], v27 offset:6144
    ds_read_b64_tr_b16 v[96:97], v27 offset:8192
    ds_read_b64_tr_b16 v[98:99], v27 offset:10240
    ds_read_b64_tr_b16 v[100:101], v27 offset:12288
    ds_read_b64_tr_b16 v[102:103], v27 offset:14336
    s_branch L_w_ok
L_aux:
    s_and_b32 s40, s2, 63
    s_lshl_b32 s40, s40, 7
    s_lshr_b32 s41, s2, 6
    s_lshl_b32 s41, s41, 14
    s_add_u32 s40, s40, s41
    s_add_u32 s40, s40, 65536
    s_and_b32 s41, s27, 1
    s_lshl_b32 s41, s41, 13
    s_or_b32 s40, s40, s41
    s_xor_b32 s41, s40, 0x2000
    s_load_dword s44, s[22:23], s40
    s_load_dword s45, s[22:23], s41
    s_waitcnt lgkmcnt(1)
    s_getreg_b32 s46, hwreg(HW_REG_IB_STS, 8, 4)
    s_cmp_lg_u32 s46, 0
    s_cselect_b32 s46, 8, 0
    s_waitcnt lgkmcnt(0)
    s_load_dword s24, s[22:23], 0
    v_mov_b32 v4, s46
    ds_write_b32 v9, v4 offset:8
    v_mov_b32 v16, 0
    v_mov_b32 v17, 0
    v_mov_b32 v20, 0
    v_mov_b32 v21, 0
    s_cmp_ge_u32 s35, 28
    s_cbranch_scc1 L_h_write
    s_lshl_b32 s90, s35, 14
    s_lshl_b32 s76, s30, 11
    s_add_u32 s90, s90, s76
    s_add_u32 s90, s90, 2621440
    s_waitcnt lgkmcnt(0)
    s_add_u32 s24, s24, 1
    s_and_b32 s25, s24, 15
    s_cselect_b32 s25, 0, 1
    s_add_u32 s24, s24, s25
L_w4_18:
    s_sub_u32 s83, s83, 1
    s_cbranch_scc1 L_out
    s_sleep 2
    ds_read_b128 v[24:27], v9 offset:32
    s_waitcnt lgkmcnt(0)
    v_min3_u32 v2, v24, v25, v26
    v_min_u32 v2, v2, v27
    v_cmp_eq_u32 vcc, 0, v2
    s_cbranch_vccnz L_w4_18
    s_sleep 20
    buffer_load_dwordx4 v[16:19], v8, s[52:55], s90 offen offset:0 sc1
    buffer_load_dwordx4 v[20:23], v8, s[52:55], s90 offen offset:1024 sc1
    s_branch L_gw_20
L_gr_19:
    v_and_b32 v10, 15, v10
    v_and_b32 v11, 15, v11
    v_cmp_ne_u32 s[60:61], 0, v10
    v_cmp_ne_u32 s[62:63], 0, v11
    s_sub_u32 s83, s83, 1
    s_cbranch_scc1 L_out
    s_wqm_b64 exec, s[60:61]
    buffer_load_dwordx4 v[16:19], v8, s[52:55], s90 offen offset:0 sc1
    s_wqm_b64 exec, s[62:63]
    buffer_load_dwordx4 v[20:23], v8, s[52:55], s90 offen offset:1024 sc1
    s_mov_b64 exec, -1
    s_waitcnt vmcnt(0)
L_gw_20:
    s_waitcnt vmcnt(1)
    v_bitop3_b32 v10, v16, v17, s24 bitop3:0x7e
    v_bitop3_b32 v10, v10, v18, s24 bitop3:0xf6
    v_bitop3_b32 v10, v10, v19, s24 bitop3:0xf6
    s_waitcnt vmcnt(0)
    v_bitop3_b32 v11, v20, v21, s24 bitop3:0x7e
    v_bitop3_b32 v11, v11, v22, s24 bitop3:0xf6
    v_bitop3_b32 v11, v11, v23, s24 bitop3:0xf6
    v_bitop3_b32 v12, v10, v11, 15 bitop3:0xa8
    v_cmp_ne_u32 vcc, 0, v12
    s_cbranch_vccnz L_gr_19
    v_bfi_b32 v16, 15, 8, v16
    v_bfi_b32 v17, 15, 8, v17
    v_bfi_b32 v18, 15, 8, v18
    v_bfi_b32 v19, 15, 8, v19
    v_bfi_b32 v20, 15, 8, v20
    v_bfi_b32 v21, 15, 8, v21
    v_bfi_b32 v22, 15, 8, v22
    v_bfi_b32 v23, 15, 8, v23
    v_add_f32 v16, v16, v20
    v_add_f32 v17, v17, v21
    v_add_f32 v18, v18, v22
    v_add_f32 v19, v19, v23
    v_mov_b32 v20, v16
    v_mov_b32 v21, v17
    v_mov_b32 v22, v18
    v_mov_b32 v23, v19
    v_permlane16_swap_b32 v16, v20
    v_permlane16_swap_b32 v17, v21
    v_permlane16_swap_b32 v18, v22
    v_permlane16_swap_b32 v19, v23
    v_add_f32 v16, v16, v20
    v_add_f32 v17, v17, v21
    v_add_f32 v18, v18, v22
    v_add_f32 v19, v19, v23
    v_mov_b32 v20, v16
    v_mov_b32 v21, v17
    v_mov_b32 v22, v18
    v_mov_b32 v23, v19
    v_permlane32_swap_b32 v16, v20
    v_permlane32_swap_b32 v17, v21
    v_permlane32_swap_b32 v18, v22
    v_permlane32_swap_b32 v19, v23
    v_add_f32 v16, v16, v20
    v_add_f32 v17, v17, v21
    v_add_f32 v18, v18, v22
    v_add_f32 v19, v19, v23
    v_cvt_pk_bf16_f32 v20, v16, v17
    v_cvt_pk_bf16_f32 v21, v18, v19
    v_lshlrev_b32 v16, 16, v20
    v_and_b32 v17, 0xffff0000, v20
    v_lshlrev_b32 v18, 16, v21
    v_and_b32 v19, 0xffff0000, v21
    v_mul_f32 v20, 0xbfb8aa3b, v16
    v_mul_f32 v21, 0xbfb8aa3b, v17
    v_mul_f32 v22, 0xbfb8aa3b, v18
    v_mul_f32 v23, 0xbfb8aa3b, v19
    v_exp_f32 v20, v20
    v_exp_f32 v21, v21
    v_exp_f32 v22, v22
    v_exp_f32 v23, v23
    v_add_f32 v20, 1.0, v20
    v_add_f32 v21, 1.0, v21
    v_add_f32 v22, 1.0, v22
    v_add_f32 v23, 1.0, v23
    v_rcp_f32 v20, v20
    v_rcp_f32 v21, v21
    v_rcp_f32 v22, v22
    v_rcp_f32 v23, v23
    v_mul_f32 v16, v16, v20
    v_mul_f32 v17, v17, v21
    v_mul_f32 v18, v18, v22
    v_mul_f32 v19, v19, v23
    v_cvt_pk_bf16_f32 v24, v16, v17
    v_cvt_pk_bf16_f32 v25, v18, v19
    v_mov_b32 v26, s24
    v_mov_b32 v27, s24
    s_lshl_b32 s90, s35, 11
    s_add_u32 s90, s90, 4096
    s_lshl_b32 s91, s30, 8
    s_add_u32 s91, s91, s90
L_w4_21:
    s_sub_u32 s83, s83, 1
    s_cbranch_scc1 L_out
    s_sleep 1
    ds_read_b128 v[32:35], v9 offset:48
    s_waitcnt lgkmcnt(0)
    v_min3_u32 v2, v32, v33, v34
    v_min_u32 v2, v2, v35
    v_cmp_eq_u32 vcc, 0, v2
    s_cbranch_vccnz L_w4_21
    v_max3_u32 v2, v32, v33, v34
    v_max_u32 v2, v2, v35
    s_nop 0
    v_readfirstlane_b32 s97, v2
    s_nop 0
    s_lshr_b32 s97, s97, 16
    s_mov_b64 exec, 0xffff
    s_cmp_eq_u32 s97, 1
    s_cbranch_scc0 L_sd_22
    buffer_store_dwordx4 v[24:27], v8, s[52:55], s91 offen
    s_branch L_sd_23
L_sd_22:
    buffer_store_dwordx4 v[24:27], v8, s[52:55], s91 offen sc1
L_sd_23:
    s_mov_b64 exec, -1
    s_sleep 24
    buffer_load_dwordx4 v[16:19], v8, s[52:55], s90 offen offset:0 sc1
    buffer_load_dwordx4 v[20:23], v8, s[52:55], s90 offen offset:1024 sc1
    s_branch L_gw_25
L_gr_24:
    s_sub_u32 s83, s83, 1
    s_cbranch_scc1 L_out
    s_mov_b64 exec, s[60:61]
    buffer_load_dwordx4 v[16:19], v8, s[52:55], s90 offen offset:0 sc1
    s_mov_b64 exec, s[62:63]
    buffer_load_dwordx4 v[20:23], v8, s[52:55], s90 offen offset:1024 sc1
    s_mov_b64 exec, -1
    s_waitcnt vmcnt(0)
L_gw_25:
    s_waitcnt vmcnt(1)
    v_cmp_ne_u32 s[60:61], s24, v19
    s_waitcnt vmcnt(0)
    v_cmp_ne_u32 s[62:63], s24, v23
    s_nop 0
    s_or_b64 s[76:77], s[60:61], s[62:63]
    s_cbranch_scc1 L_gr_24
L_h_write:
    v_lshlrev_b32 v3, 3, v1
    v_add_u32 v3, 156672, v3
    v_mov_b32 v4, 1
    ds_write_b64 v3, v[16:17]
    ds_write_b64 v3, v[20:21] offset:512
    ds_write_b32 v9, v4 offset:4
    s_waitcnt lgkmcnt(0)
L_out:
L_end:
    s_endpgm
    .fill (12544 - (L_end - L_start)) / 4, 4, 0xbf810000
.section .rodata,"a"
.p2align 6
.amdhsa_kernel parallel_sum__sliding_block_cached__dense_activation_silu__decode_kernel
  .amdhsa_next_free_vgpr 256
  .amdhsa_next_free_sgpr 102
  .amdhsa_accum_offset 256
  .amdhsa_group_segment_fixed_size 0
  .amdhsa_kernarg_size 88
  .amdhsa_user_sgpr_count 2
  .amdhsa_user_sgpr_kernarg_segment_ptr 1
  .amdhsa_system_sgpr_workgroup_id_x 1
  .amdhsa_float_denorm_mode_32 3
.end_amdhsa_kernel
```
